```python
import torch

def _softmax(x, axis=-1):
    return torch.softmax(x, dim=axis)
def _gelu(x):
    return torch.nn.functional.gelu(x, approximate="tanh")
def _silu(x):
    return torch.nn.functional.silu(x)
def _sigmoid(x):
    return torch.sigmoid(x)
def _layernorm(x, axis=-1, eps=1e-5):
    m = x.mean(dim=axis, keepdim=True)
    v = x.var(dim=axis, keepdim=True, unbiased=False)
    return (x - m) / torch.sqrt(v + eps)
def _scatter_add(tgt, idx, src, axis=0):
    return tgt.clone().index_add_(axis, idx, src)
def _segment_sum(src, seg, n):
    out = torch.zeros((n,) + src.shape[1:], dtype=src.dtype)
    return out.index_add_(0, seg, src)
def _pad(x, pw):
    flat = tuple(v for pair in reversed(pw) for v in pair)
    return torch.nn.functional.pad(x, flat)

kernel_name = 'standalone__glu_gated_glu__decode'

def setup_inputs():

    _w = (lambda a: (lambda t: t.to(torch.bfloat16) if t.is_floating_point() else t)(torch.as_tensor(a)))
    B, S, D, F = 4, 1, 1024, 3584
    return {
        "x": _w((lambda *s: torch.randn(*s, dtype=torch.bfloat16) * 0.1)(B, S, D)),
        "w_gate": _w((lambda *s: torch.randn(*s, dtype=torch.bfloat16) * 0.1)(D, F)),
        "w_up": _w((lambda *s: torch.randn(*s, dtype=torch.bfloat16) * 0.05)(D, F)),
        "w_down": _w((lambda *s: torch.randn(*s, dtype=torch.bfloat16) * 0.05)(F, D)),
    }

def reference(x, w_gate, w_up, w_down):
    g = torch.einsum("bsd,df->bsf", x, w_gate)
    u = torch.einsum("bsd,df->bsf", x, w_up)
    h = _sigmoid(g) * u
    return torch.einsum("bsf,fd->bsd", h, w_down)
```

```asm
; @launch grid=(224,1,1) block=(512,1,1) lds=17408
.amdgcn_target "amdgcn-amd-amdhsa--gfx950"
.text
.globl standalone__glu_gated_glu__decode_kernel
.p2align 8
.type standalone__glu_gated_glu__decode_kernel,@function
standalone__glu_gated_glu__decode_kernel:
s_load_dwordx8 s[4:11], s[0:1], 0
s_load_dwordx4 s[12:15], s[0:1], 32
s_load_dwordx2 s[16:17], s[0:1], 48
s_cmp_ge_u32 s2, 224
s_cbranch_scc1 L_end
v_lshrrev_b32 v2, 6, v0
v_and_b32 v1, 63, v0
s_lshr_b32 s18, s2, 3
v_readfirstlane_b32 s3, v2
s_and_b32 s19, s2, 7
s_and_b32 s44, s19, 1
s_lshr_b32 s45, s19, 1
v_lshrrev_b32 v2, 4, v1
v_and_b32 v3, 15, v1
s_cmp_ge_u32 s3, 4
s_cbranch_scc1 L_helper
v_mul_u32_u24 v4, 114688, v2
v_lshl_add_u32 v4, v3, 4, v4
v_lshrrev_b32 v5, 2, v3
v_lshlrev_b32 v6, 11, v5
v_lshl_add_u32 v6, v2, 5, v6
s_lshl_b32 s47, s45, 2
s_add_u32 s47, s47, s3
s_lshl_b32 s56, s47, 7
s_mul_i32 s57, s47, 458752
s_lshl_b32 s58, s18, 8
s_add_u32 s57, s57, s58
s_mov_b32 s22, 7340032
s_mov_b32 s23, 0x00020000
s_mov_b32 s30, 8192
s_mov_b32 s31, 0x00020000
s_cmp_eq_u32 s44, 0
s_waitcnt lgkmcnt(0)
s_cselect_b32 s20, s6, s8
s_cselect_b32 s21, s7, s9
s_mov_b32 s28, s4
s_mov_b32 s29, s5
buffer_load_dwordx4 v[8:11], v6, s[28:31], s56 offen
buffer_load_dwordx4 v[12:15], v6, s[28:31], s56 offen offset:16
buffer_load_dwordx4 v[64:67], v4, s[20:23], s57 offen nt
s_add_u32 s57, s57, 7168
buffer_load_dwordx4 v[68:71], v4, s[20:23], s57 offen nt
s_add_u32 s57, s57, 7168
buffer_load_dwordx4 v[72:75], v4, s[20:23], s57 offen nt
s_add_u32 s57, s57, 7168
buffer_load_dwordx4 v[76:79], v4, s[20:23], s57 offen nt
s_add_u32 s57, s57, 7168
buffer_load_dwordx4 v[80:83], v4, s[20:23], s57 offen nt
s_add_u32 s57, s57, 7168
buffer_load_dwordx4 v[84:87], v4, s[20:23], s57 offen nt
s_add_u32 s57, s57, 7168
buffer_load_dwordx4 v[88:91], v4, s[20:23], s57 offen nt
s_add_u32 s57, s57, 7168
buffer_load_dwordx4 v[92:95], v4, s[20:23], s57 offen nt
s_add_u32 s57, s57, 7168
buffer_load_dwordx4 v[96:99], v4, s[20:23], s57 offen nt
s_add_u32 s57, s57, 7168
buffer_load_dwordx4 v[100:103], v4, s[20:23], s57 offen nt
s_add_u32 s57, s57, 7168
buffer_load_dwordx4 v[104:107], v4, s[20:23], s57 offen nt
s_add_u32 s57, s57, 7168
buffer_load_dwordx4 v[108:111], v4, s[20:23], s57 offen nt
s_add_u32 s57, s57, 7168
buffer_load_dwordx4 v[112:115], v4, s[20:23], s57 offen nt
s_add_u32 s57, s57, 7168
buffer_load_dwordx4 v[116:119], v4, s[20:23], s57 offen nt
s_add_u32 s57, s57, 7168
buffer_load_dwordx4 v[120:123], v4, s[20:23], s57 offen nt
s_add_u32 s57, s57, 7168
buffer_load_dwordx4 v[124:127], v4, s[20:23], s57 offen nt
s_mov_b32 s24, s10
s_mov_b32 s25, s11
s_mov_b32 s26, 7340032
s_mov_b32 s27, 0x00020000
v_lshlrev_b32 v7, 14, v2
v_lshl_add_u32 v7, v3, 4, v7
s_lshl_b32 s58, s18, 2
s_add_u32 s58, s58, s3
s_lshl_b32 s58, s58, 16
s_lshl_b32 s59, s19, 8
s_add_u32 s58, s58, s59
s_add_u32 s52, s16, 3145728
s_addc_u32 s53, s17, 0
s_load_dword s98, s[52:53], 0
s_mov_b32 s32, s16
s_mov_b32 s33, s17
s_mov_b32 s34, 458752
s_mov_b32 s35, 0x00020000
s_add_u32 s48, s16, 1048576
s_addc_u32 s49, s17, 0
s_mov_b32 s50, 458752
s_mov_b32 s51, 0x00020000
s_mov_b32 s40, s12
s_mov_b32 s41, s13
s_mov_b32 s42, 8192
s_mov_b32 s43, 0x00020000
s_mov_b32 s54, 256
s_mov_b32 s55, 0x00020000
s_lshl_b32 s46, s2, 11
s_add_u32 s76, s16, 1572864
s_addc_u32 s77, s17, 0
s_mov_b32 s78, 458752
s_mov_b32 s79, 0x00020000
v_and_b32 v48, 1, v1
v_cmp_eq_u32 vcc, 1, v48
v_mov_b32 v49, 0x0c0c0100
v_mov_b32 v50, 0x01000c0c
v_cndmask_b32 v60, v49, v50, vcc
v_mov_b32 v49, 0x0c0c0302
v_mov_b32 v50, 0x03020c0c
v_cndmask_b32 v61, v49, v50, vcc
v_and_b32 v48, 2, v1
v_cmp_eq_u32 s[90:91], 2, v48
v_mov_b32 v62, 0x0c0c0c0c
s_nop 0
v_cndmask_b32 v48, v60, v62, s[90:91]
v_cndmask_b32 v49, v61, v62, s[90:91]
v_cndmask_b32 v50, v62, v60, s[90:91]
v_cndmask_b32 v51, v62, v61, s[90:91]
v_mov_b32 v52, 0
v_mov_b32 v53, 0
v_mov_b32 v54, 0
v_mov_b32 v55, 0
v_mov_b32 v56, 0
v_mov_b32 v57, 0
v_mov_b32 v58, 0
v_mov_b32 v59, 0
s_waitcnt lgkmcnt(0)
s_xor_b32 s84, s98, 0x3c6ef372
s_mul_i32 s84, s84, 0x9e3779b1
s_lshr_b32 s84, s84, 20
s_xor_b32 s85, s98, 0x78dde6e4
s_mul_i32 s85, s85, 0x85ebca77
s_lshr_b32 s85, s85, 20
s_xor_b32 s86, s98, 0xb54cda56
s_mul_i32 s86, s86, 0xc2b2ae3d
s_lshr_b32 s86, s86, 20
s_xor_b32 s87, s98, 0xf1bbcdc8
s_mul_i32 s87, s87, 0x27d4eb2f
s_lshr_b32 s87, s87, 20
s_mov_b32 s88, 0xfffff000
s_waitcnt vmcnt(16)
v_perm_b32 v16, v8, v8, v48
v_perm_b32 v17, v8, v8, v50
v_perm_b32 v18, v8, v8, v49
v_perm_b32 v19, v8, v8, v51
v_perm_b32 v20, v9, v9, v48
v_perm_b32 v21, v9, v9, v50
v_perm_b32 v22, v9, v9, v49
v_perm_b32 v23, v9, v9, v51
v_perm_b32 v24, v10, v10, v48
v_perm_b32 v25, v10, v10, v50
v_perm_b32 v26, v10, v10, v49
v_perm_b32 v27, v10, v10, v51
v_perm_b32 v28, v11, v11, v48
v_perm_b32 v29, v11, v11, v50
v_perm_b32 v30, v11, v11, v49
v_perm_b32 v31, v11, v11, v51
v_perm_b32 v32, v12, v12, v48
v_perm_b32 v33, v12, v12, v50
v_perm_b32 v34, v12, v12, v49
v_perm_b32 v35, v12, v12, v51
v_perm_b32 v36, v13, v13, v48
v_perm_b32 v37, v13, v13, v50
v_perm_b32 v38, v13, v13, v49
v_perm_b32 v39, v13, v13, v51
v_perm_b32 v40, v14, v14, v48
v_perm_b32 v41, v14, v14, v50
v_perm_b32 v42, v14, v14, v49
v_perm_b32 v43, v14, v14, v51
v_perm_b32 v44, v15, v15, v48
v_perm_b32 v45, v15, v15, v50
v_perm_b32 v46, v15, v15, v49
v_perm_b32 v47, v15, v15, v51
s_lshl_b32 s59, s3, 11
v_lshlrev_b32 v60, 5, v1
v_add_u32 v60, s59, v60
v_lshlrev_b32 v61, 4, v0
s_lshl_b32 s59, s3, 8
v_lshlrev_b32 v4, 6, v5
v_lshl_add_u32 v4, v2, 4, v4
v_add_u32 v4, s59, v4
s_waitcnt vmcnt(15)
v_mfma_f32_16x16x16_bf16 v[52:55], v[16:17], v[64:65], v[52:55]
v_mfma_f32_16x16x16_bf16 v[56:59], v[16:17], v[66:67], v[56:59]
s_waitcnt vmcnt(14)
v_mfma_f32_16x16x16_bf16 v[52:55], v[18:19], v[68:69], v[52:55]
v_mfma_f32_16x16x16_bf16 v[56:59], v[18:19], v[70:71], v[56:59]
s_waitcnt vmcnt(13)
v_mfma_f32_16x16x16_bf16 v[52:55], v[20:21], v[72:73], v[52:55]
v_mfma_f32_16x16x16_bf16 v[56:59], v[20:21], v[74:75], v[56:59]
s_waitcnt vmcnt(12)
v_mfma_f32_16x16x16_bf16 v[52:55], v[22:23], v[76:77], v[52:55]
v_mfma_f32_16x16x16_bf16 v[56:59], v[22:23], v[78:79], v[56:59]
s_waitcnt vmcnt(11)
v_mfma_f32_16x16x16_bf16 v[52:55], v[24:25], v[80:81], v[52:55]
v_mfma_f32_16x16x16_bf16 v[56:59], v[24:25], v[82:83], v[56:59]
s_waitcnt vmcnt(10)
v_mfma_f32_16x16x16_bf16 v[52:55], v[26:27], v[84:85], v[52:55]
v_mfma_f32_16x16x16_bf16 v[56:59], v[26:27], v[86:87], v[56:59]
s_waitcnt vmcnt(9)
v_mfma_f32_16x16x16_bf16 v[52:55], v[28:29], v[88:89], v[52:55]
v_mfma_f32_16x16x16_bf16 v[56:59], v[28:29], v[90:91], v[56:59]
s_waitcnt vmcnt(8)
v_mfma_f32_16x16x16_bf16 v[52:55], v[30:31], v[92:93], v[52:55]
v_mfma_f32_16x16x16_bf16 v[56:59], v[30:31], v[94:95], v[56:59]
buffer_load_dwordx4 v[128:131], v7, s[24:27], s58 offen nt
s_add_u32 s58, s58, 2048
buffer_load_dwordx4 v[132:135], v7, s[24:27], s58 offen nt
s_add_u32 s58, s58, 2048
buffer_load_dwordx4 v[136:139], v7, s[24:27], s58 offen nt
s_add_u32 s58, s58, 2048
buffer_load_dwordx4 v[140:143], v7, s[24:27], s58 offen nt
s_add_u32 s58, s58, 2048
buffer_load_dwordx4 v[144:147], v7, s[24:27], s58 offen nt
s_add_u32 s58, s58, 2048
buffer_load_dwordx4 v[148:151], v7, s[24:27], s58 offen nt
s_add_u32 s58, s58, 2048
buffer_load_dwordx4 v[152:155], v7, s[24:27], s58 offen nt
s_add_u32 s58, s58, 2048
buffer_load_dwordx4 v[156:159], v7, s[24:27], s58 offen nt
s_waitcnt vmcnt(15)
v_mfma_f32_16x16x16_bf16 v[52:55], v[32:33], v[96:97], v[52:55]
v_mfma_f32_16x16x16_bf16 v[56:59], v[32:33], v[98:99], v[56:59]
s_waitcnt vmcnt(14)
v_mfma_f32_16x16x16_bf16 v[52:55], v[34:35], v[100:101], v[52:55]
v_mfma_f32_16x16x16_bf16 v[56:59], v[34:35], v[102:103], v[56:59]
s_waitcnt vmcnt(13)
v_mfma_f32_16x16x16_bf16 v[52:55], v[36:37], v[104:105], v[52:55]
v_mfma_f32_16x16x16_bf16 v[56:59], v[36:37], v[106:107], v[56:59]
s_waitcnt vmcnt(12)
v_mfma_f32_16x16x16_bf16 v[52:55], v[38:39], v[108:109], v[52:55]
v_mfma_f32_16x16x16_bf16 v[56:59], v[38:39], v[110:111], v[56:59]
s_waitcnt vmcnt(11)
v_mfma_f32_16x16x16_bf16 v[52:55], v[40:41], v[112:113], v[52:55]
v_mfma_f32_16x16x16_bf16 v[56:59], v[40:41], v[114:115], v[56:59]
s_waitcnt vmcnt(10)
v_mfma_f32_16x16x16_bf16 v[52:55], v[42:43], v[116:117], v[52:55]
v_mfma_f32_16x16x16_bf16 v[56:59], v[42:43], v[118:119], v[56:59]
s_waitcnt vmcnt(9)
v_mfma_f32_16x16x16_bf16 v[52:55], v[44:45], v[120:121], v[52:55]
v_mfma_f32_16x16x16_bf16 v[56:59], v[44:45], v[122:123], v[56:59]
s_waitcnt vmcnt(8)
v_mfma_f32_16x16x16_bf16 v[52:55], v[46:47], v[124:125], v[52:55]
v_mfma_f32_16x16x16_bf16 v[56:59], v[46:47], v[126:127], v[56:59]
s_nop 7
ds_write_b128 v60, v[52:55] offset:0
ds_write_b128 v60, v[56:59] offset:16
s_waitcnt lgkmcnt(0)
s_barrier
s_cmp_ge_u32 s3, 2
s_cbranch_scc1 L_np1
ds_read_b128 v[20:23], v61 offset:0
ds_read_b128 v[24:27], v61 offset:2048
ds_read_b128 v[28:31], v61 offset:4096
ds_read_b128 v[32:35], v61 offset:6144
s_waitcnt lgkmcnt(0)
v_add_f32 v20, v20, v24
v_add_f32 v28, v28, v32
v_add_f32 v21, v21, v25
v_add_f32 v29, v29, v33
v_add_f32 v22, v22, v26
v_add_f32 v30, v30, v34
v_add_f32 v23, v23, v27
v_add_f32 v31, v31, v35
v_add_f32 v20, v20, v28
v_add_f32 v21, v21, v29
v_add_f32 v22, v22, v30
v_add_f32 v23, v23, v31
v_add_u32 v20, 0x800, v20
v_add_u32 v21, 0x800, v21
v_add_u32 v22, 0x800, v22
v_add_u32 v23, 0x800, v23
v_mov_b32 v24, s84
v_mov_b32 v25, s85
v_mov_b32 v26, s86
v_mov_b32 v27, s87
v_and_or_b32 v20, v20, s88, v24
v_and_or_b32 v21, v21, s88, v25
v_and_or_b32 v22, v22, s88, v26
v_and_or_b32 v23, v23, s88, v27
buffer_store_dwordx4 v[20:23], v61, s[32:35], s46 offen sc0 sc1
L_np1:
s_cmp_ge_u32 s3, 2
s_cbranch_scc1 L_b1b_a
s_waitcnt vmcnt(5)
s_branch L_b1b_b
L_b1b_a:
s_waitcnt vmcnt(4)
L_b1b_b:
s_barrier
v_mov_b32 v52, 0
v_mov_b32 v53, 0
v_mov_b32 v54, 0
v_mov_b32 v55, 0
v_mov_b32 v56, 0
v_mov_b32 v57, 0
v_mov_b32 v58, 0
v_mov_b32 v59, 0
s_barrier
ds_read_b128 v[8:11], v4 offset:16384
s_waitcnt lgkmcnt(0)
v_perm_b32 v16, v8, v8, v48
v_perm_b32 v17, v8, v8, v50
v_perm_b32 v18, v8, v8, v49
v_perm_b32 v19, v8, v8, v51
v_perm_b32 v20, v9, v9, v48
v_perm_b32 v21, v9, v9, v50
v_perm_b32 v22, v9, v9, v49
v_perm_b32 v23, v9, v9, v51
v_perm_b32 v24, v10, v10, v48
v_perm_b32 v25, v10, v10, v50
v_perm_b32 v26, v10, v10, v49
v_perm_b32 v27, v10, v10, v51
v_perm_b32 v28, v11, v11, v48
v_perm_b32 v29, v11, v11, v50
v_perm_b32 v30, v11, v11, v49
v_perm_b32 v31, v11, v11, v51
s_waitcnt vmcnt(7)
v_mfma_f32_16x16x16_bf16 v[52:55], v[16:17], v[128:129], v[52:55]
v_mfma_f32_16x16x16_bf16 v[56:59], v[16:17], v[130:131], v[56:59]
s_waitcnt vmcnt(6)
v_mfma_f32_16x16x16_bf16 v[52:55], v[18:19], v[132:133], v[52:55]
v_mfma_f32_16x16x16_bf16 v[56:59], v[18:19], v[134:135], v[56:59]
s_waitcnt vmcnt(5)
v_mfma_f32_16x16x16_bf16 v[52:55], v[20:21], v[136:137], v[52:55]
v_mfma_f32_16x16x16_bf16 v[56:59], v[20:21], v[138:139], v[56:59]
s_waitcnt vmcnt(4)
v_mfma_f32_16x16x16_bf16 v[52:55], v[22:23], v[140:141], v[52:55]
v_mfma_f32_16x16x16_bf16 v[56:59], v[22:23], v[142:143], v[56:59]
s_waitcnt vmcnt(3)
v_mfma_f32_16x16x16_bf16 v[52:55], v[24:25], v[144:145], v[52:55]
v_mfma_f32_16x16x16_bf16 v[56:59], v[24:25], v[146:147], v[56:59]
s_waitcnt vmcnt(2)
v_mfma_f32_16x16x16_bf16 v[52:55], v[26:27], v[148:149], v[52:55]
v_mfma_f32_16x16x16_bf16 v[56:59], v[26:27], v[150:151], v[56:59]
s_waitcnt vmcnt(1)
v_mfma_f32_16x16x16_bf16 v[52:55], v[28:29], v[152:153], v[52:55]
v_mfma_f32_16x16x16_bf16 v[56:59], v[28:29], v[154:155], v[56:59]
s_waitcnt vmcnt(0)
v_mfma_f32_16x16x16_bf16 v[52:55], v[30:31], v[156:157], v[52:55]
v_mfma_f32_16x16x16_bf16 v[56:59], v[30:31], v[158:159], v[56:59]
s_nop 7
ds_write_b128 v60, v[52:55] offset:8192
ds_write_b128 v60, v[56:59] offset:8208
s_waitcnt lgkmcnt(0)
s_barrier
s_cmp_ge_u32 s3, 2
s_cbranch_scc1 L_np2
ds_read_b128 v[20:23], v61 offset:8192
ds_read_b128 v[24:27], v61 offset:10240
ds_read_b128 v[28:31], v61 offset:12288
ds_read_b128 v[32:35], v61 offset:14336
s_waitcnt lgkmcnt(0)
v_add_f32 v20, v20, v24
v_add_f32 v28, v28, v32
v_add_f32 v21, v21, v25
v_add_f32 v29, v29, v33
v_add_f32 v22, v22, v26
v_add_f32 v30, v30, v34
v_add_f32 v23, v23, v27
v_add_f32 v31, v31, v35
v_add_f32 v20, v20, v28
v_add_f32 v21, v21, v29
v_add_f32 v22, v22, v30
v_add_f32 v23, v23, v31
v_add_u32 v20, 0x800, v20
v_add_u32 v21, 0x800, v21
v_add_u32 v22, 0x800, v22
v_add_u32 v23, 0x800, v23
v_mov_b32 v24, s84
v_mov_b32 v25, s85
v_mov_b32 v26, s86
v_mov_b32 v27, s87
v_and_or_b32 v20, v20, s88, v24
v_and_or_b32 v21, v21, s88, v25
v_and_or_b32 v22, v22, s88, v26
v_and_or_b32 v23, v23, s88, v27
buffer_store_dwordx4 v[20:23], v61, s[76:79], s46 offen
buffer_store_dwordx4 v[20:23], v61, s[48:51], s46 offen sc0 sc1
L_np2:
s_cmp_lg_u32 s3, 2
s_cbranch_scc1 L_fin
s_cmp_ge_u32 s18, 16
s_cbranch_scc1 L_fin
v_lshrrev_b32 v22, 3, v1
v_and_b32 v23, 7, v1
v_lshlrev_b32 v22, 14, v22
v_lshl_add_u32 v22, v23, 4, v22
s_lshl_b32 s92, s19, 11
s_lshl_b32 s59, s18, 7
s_add_u32 s92, s92, s59
s_add_u32 s93, s92, 0x20000
s_add_u32 s94, s92, 0x40000
s_add_u32 s95, s92, 0x60000
v_cmp_gt_u32 vcc, 32, v1
s_mov_b32 s96, 0
v_mov_b32 v44, s84
v_cndmask_b32 v44, 0, v44, vcc
v_mov_b32 v45, s85
v_cndmask_b32 v45, 0, v45, vcc
v_mov_b32 v46, s86
v_cndmask_b32 v46, 0, v46, vcc
v_mov_b32 v47, s87
v_cndmask_b32 v47, 0, v47, vcc
L_hop2:
s_add_u32 s96, s96, 1
s_cmp_gt_u32 s96, 0x40000
s_cbranch_scc1 L_end
s_and_b32 s59, s96, 3
s_cmp_eq_u32 s59, 0
s_cbranch_scc1 L_h2B
buffer_load_dwordx4 v[24:27], v22, s[76:79], s92 offen nt
buffer_load_dwordx4 v[28:31], v22, s[76:79], s93 offen nt
buffer_load_dwordx4 v[32:35], v22, s[76:79], s94 offen nt
buffer_load_dwordx4 v[36:39], v22, s[76:79], s95 offen nt
s_branch L_h2w
L_h2B:
buffer_load_dwordx4 v[24:27], v22, s[48:51], s92 offen sc0 sc1
buffer_load_dwordx4 v[28:31], v22, s[48:51], s93 offen sc0 sc1
buffer_load_dwordx4 v[32:35], v22, s[48:51], s94 offen sc0 sc1
buffer_load_dwordx4 v[36:39], v22, s[48:51], s95 offen sc0 sc1
L_h2w:
s_waitcnt vmcnt(0)
v_xor_b32 v40, s84, v24
v_xor_b32 v41, s85, v25
v_or_b32 v40, v40, v41
v_xor_b32 v41, s86, v26
v_or_b32 v40, v40, v41
v_xor_b32 v41, s87, v27
v_or_b32 v40, v40, v41
v_xor_b32 v41, s84, v28
v_or_b32 v40, v40, v41
v_xor_b32 v41, s85, v29
v_or_b32 v40, v40, v41
v_xor_b32 v41, s86, v30
v_or_b32 v40, v40, v41
v_xor_b32 v41, s87, v31
v_or_b32 v40, v40, v41
v_xor_b32 v41, s84, v32
v_or_b32 v40, v40, v41
v_xor_b32 v41, s85, v33
v_or_b32 v40, v40, v41
v_xor_b32 v41, s86, v34
v_or_b32 v40, v40, v41
v_xor_b32 v41, s87, v35
v_or_b32 v40, v40, v41
v_xor_b32 v41, v44, v36
v_or_b32 v40, v40, v41
v_xor_b32 v41, v45, v37
v_or_b32 v40, v40, v41
v_xor_b32 v41, v46, v38
v_or_b32 v40, v40, v41
v_xor_b32 v41, v47, v39
v_or_b32 v40, v40, v41
v_and_b32 v40, 0xfff, v40
v_cmp_ne_u32 vcc, 0, v40
s_cbranch_vccnz L_hop2
v_and_b32 v24, s88, v24
v_and_b32 v25, s88, v25
v_and_b32 v26, s88, v26
v_and_b32 v27, s88, v27
v_and_b32 v28, s88, v28
v_and_b32 v29, s88, v29
v_and_b32 v30, s88, v30
v_and_b32 v31, s88, v31
v_and_b32 v32, s88, v32
v_and_b32 v33, s88, v33
v_and_b32 v34, s88, v34
v_and_b32 v35, s88, v35
v_and_b32 v36, s88, v36
v_and_b32 v37, s88, v37
v_and_b32 v38, s88, v38
v_and_b32 v39, s88, v39
v_add_f32 v24, v24, v28
v_add_f32 v32, v32, v36
v_add_f32 v25, v25, v29
v_add_f32 v33, v33, v37
v_add_f32 v26, v26, v30
v_add_f32 v34, v34, v38
v_add_f32 v27, v27, v31
v_add_f32 v35, v35, v39
v_add_f32 v24, v24, v32
v_add_f32 v25, v25, v33
v_add_f32 v26, v26, v34
v_add_f32 v27, v27, v35
s_nop 1
v_add_f32_dpp v24, v24, v24 row_ror:8 row_mask:0xf bank_mask:0xf
v_add_f32_dpp v25, v25, v25 row_ror:8 row_mask:0xf bank_mask:0xf
v_add_f32_dpp v26, v26, v26 row_ror:8 row_mask:0xf bank_mask:0xf
v_add_f32_dpp v27, v27, v27 row_ror:8 row_mask:0xf bank_mask:0xf
v_mov_b32 v28, v24
v_mov_b32 v29, v25
v_mov_b32 v30, v26
v_mov_b32 v31, v27
s_nop 1
v_permlane16_swap_b32 v24, v28
v_permlane16_swap_b32 v25, v29
v_permlane16_swap_b32 v26, v30
v_permlane16_swap_b32 v27, v31
s_nop 1
v_add_f32 v24, v24, v28
v_add_f32 v25, v25, v29
v_add_f32 v26, v26, v30
v_add_f32 v27, v27, v31
v_mov_b32 v28, v24
v_mov_b32 v29, v25
v_mov_b32 v30, v26
v_mov_b32 v31, v27
s_nop 1
v_permlane32_swap_b32 v24, v28
v_permlane32_swap_b32 v25, v29
v_permlane32_swap_b32 v26, v30
v_permlane32_swap_b32 v27, v31
s_nop 1
v_add_f32 v24, v24, v28
v_add_f32 v25, v25, v29
v_add_f32 v26, v26, v30
v_add_f32 v27, v27, v31
v_cvt_pk_bf16_f32 v24, v24, v25
v_cvt_pk_bf16_f32 v25, v26, v27
s_lshr_b32 s92, s18, 2
s_lshl_b32 s92, s92, 11
s_lshl_b32 s93, s19, 8
s_add_u32 s92, s92, s93
s_and_b32 s93, s18, 3
s_lshl_b32 s93, s93, 6
s_add_u32 s92, s92, s93
v_lshlrev_b32 v23, 3, v23
s_mov_b64 exec, 0xff
buffer_store_dwordx2 v[24:25], v23, s[40:43], s92 offen
s_cmp_lg_u32 s2, 0
s_cbranch_scc1 L_fin
s_add_u32 s98, s98, 1
v_mov_b32 v26, s98
v_mov_b32 v27, 0
s_mov_b64 exec, 1
buffer_store_dword v26, v27, s[52:55], 0 offen
s_branch L_fin
L_helper:
s_waitcnt lgkmcnt(0)
s_add_u32 s52, s16, 3145728
s_addc_u32 s53, s17, 0
s_load_dword s98, s[52:53], 0
s_mov_b32 s32, s16
s_mov_b32 s33, s17
s_mov_b32 s34, 458752
s_mov_b32 s35, 0x00020000
s_add_u32 s48, s16, 1048576
s_addc_u32 s49, s17, 0
s_mov_b32 s50, 458752
s_mov_b32 s51, 0x00020000
s_mov_b32 s40, s12
s_mov_b32 s41, s13
s_mov_b32 s42, 8192
s_mov_b32 s43, 0x00020000
s_mov_b32 s54, 256
s_mov_b32 s55, 0x00020000
s_lshl_b32 s46, s2, 11
s_add_u32 s76, s16, 1572864
s_addc_u32 s77, s17, 0
s_mov_b32 s78, 458752
s_mov_b32 s79, 0x00020000
s_sub_u32 s3, s3, 4
v_lshrrev_b32 v4, 5, v1
v_bfe_u32 v5, v1, 3, 2
v_and_b32 v6, 7, v1
v_lshlrev_b32 v47, 11, v4
v_lshl_add_u32 v47, v5, 9, v47
v_lshl_add_u32 v47, v6, 4, v47
s_lshl_b32 s59, s3, 7
v_add_u32 v47, s59, v47
s_lshl_b32 s92, s18, 14
s_add_u32 s93, s92, 4096
s_add_u32 s94, s92, 8192
s_add_u32 s95, s92, 12288
s_lshl_b32 s59, s3, 8
v_lshlrev_b32 v46, 6, v5
v_lshl_add_u32 v46, v6, 3, v46
v_lshl_add_u32 v46, v4, 2, v46
v_add_u32 v46, s59, v46
s_mov_b32 s96, 0
s_waitcnt lgkmcnt(0)
s_xor_b32 s84, s98, 0x3c6ef372
s_mul_i32 s84, s84, 0x9e3779b1
s_lshr_b32 s84, s84, 20
s_xor_b32 s85, s98, 0x78dde6e4
s_mul_i32 s85, s85, 0x85ebca77
s_lshr_b32 s85, s85, 20
s_xor_b32 s86, s98, 0xb54cda56
s_mul_i32 s86, s86, 0xc2b2ae3d
s_lshr_b32 s86, s86, 20
s_xor_b32 s87, s98, 0xf1bbcdc8
s_mul_i32 s87, s87, 0x27d4eb2f
s_lshr_b32 s87, s87, 20
s_mov_b32 s88, 0xfffff000
s_mov_b32 s97, 0
s_barrier
s_barrier
L_hop1:
s_add_u32 s96, s96, 1
s_cmp_gt_u32 s96, 0x40000
s_cbranch_scc1 L_end
s_bitcmp1_b32 s97, 0
s_cbranch_scc1 L_h1s0
buffer_load_dwordx4 v[24:27], v47, s[32:35], s92 offen sc0 sc1
L_h1s0:
s_bitcmp1_b32 s97, 1
s_cbranch_scc1 L_h1s1
buffer_load_dwordx4 v[28:31], v47, s[32:35], s93 offen sc0 sc1
L_h1s1:
s_bitcmp1_b32 s97, 2
s_cbranch_scc1 L_h1s2
buffer_load_dwordx4 v[32:35], v47, s[32:35], s94 offen sc0 sc1
L_h1s2:
s_bitcmp1_b32 s97, 3
s_cbranch_scc1 L_h1s3
buffer_load_dwordx4 v[36:39], v47, s[32:35], s95 offen sc0 sc1
L_h1s3:
s_waitcnt vmcnt(0)
v_xor_b32 v40, s84, v24
v_xor_b32 v41, s85, v25
v_xor_b32 v42, s86, v26
v_xor_b32 v43, s87, v27
v_or3_b32 v40, v40, v41, v42
v_or_b32 v40, v40, v43
v_and_b32 v40, 0xfff, v40
v_cmp_ne_u32 vcc, 0, v40
s_cbranch_vccnz L_h1c0
s_bitset1_b32 s97, 0
L_h1c0:
v_xor_b32 v40, s84, v28
v_xor_b32 v41, s85, v29
v_xor_b32 v42, s86, v30
v_xor_b32 v43, s87, v31
v_or3_b32 v40, v40, v41, v42
v_or_b32 v40, v40, v43
v_and_b32 v40, 0xfff, v40
v_cmp_ne_u32 vcc, 0, v40
s_cbranch_vccnz L_h1c1
s_bitset1_b32 s97, 1
L_h1c1:
v_xor_b32 v40, s84, v32
v_xor_b32 v41, s85, v33
v_xor_b32 v42, s86, v34
v_xor_b32 v43, s87, v35
v_or3_b32 v40, v40, v41, v42
v_or_b32 v40, v40, v43
v_and_b32 v40, 0xfff, v40
v_cmp_ne_u32 vcc, 0, v40
s_cbranch_vccnz L_h1c2
s_bitset1_b32 s97, 2
L_h1c2:
v_xor_b32 v40, s84, v36
v_xor_b32 v41, s85, v37
v_xor_b32 v42, s86, v38
v_xor_b32 v43, s87, v39
v_or3_b32 v40, v40, v41, v42
v_or_b32 v40, v40, v43
v_and_b32 v40, 0xfff, v40
v_cmp_ne_u32 vcc, 0, v40
s_cbranch_vccnz L_h1c3
s_bitset1_b32 s97, 3
L_h1c3:
s_cmp_lg_u32 s97, 0xf
s_cbranch_scc1 L_hop1
v_and_b32 v24, s88, v24
v_and_b32 v25, s88, v25
v_and_b32 v26, s88, v26
v_and_b32 v27, s88, v27
v_and_b32 v28, s88, v28
v_and_b32 v29, s88, v29
v_and_b32 v30, s88, v30
v_and_b32 v31, s88, v31
v_and_b32 v32, s88, v32
v_and_b32 v33, s88, v33
v_and_b32 v34, s88, v34
v_and_b32 v35, s88, v35
v_and_b32 v36, s88, v36
v_and_b32 v37, s88, v37
v_and_b32 v38, s88, v38
v_and_b32 v39, s88, v39
v_add_f32 v24, v24, v28
v_add_f32 v32, v32, v36
v_add_f32 v25, v25, v29
v_add_f32 v33, v33, v37
v_add_f32 v26, v26, v30
v_add_f32 v34, v34, v38
v_add_f32 v27, v27, v31
v_add_f32 v35, v35, v39
v_add_f32 v24, v24, v32
v_add_f32 v25, v25, v33
v_add_f32 v26, v26, v34
v_add_f32 v27, v27, v35
s_nop 1
v_permlane32_swap_b32 v24, v26
v_permlane32_swap_b32 v25, v27
s_nop 1
v_mul_f32 v24, 0xbfb8aa3b, v24
v_mul_f32 v25, 0xbfb8aa3b, v25
v_exp_f32 v24, v24
v_exp_f32 v25, v25
s_nop 0
v_add_f32 v24, 1.0, v24
v_add_f32 v25, 1.0, v25
v_rcp_f32 v24, v24
v_rcp_f32 v25, v25
s_nop 0
v_mul_f32 v24, v24, v26
v_mul_f32 v25, v25, v27
v_cvt_pk_bf16_f32 v24, v24, v25
ds_write_b32 v46, v24 offset:16384
s_waitcnt lgkmcnt(0)
s_barrier
s_add_u32 s3, s3, 4
L_fin:
L_end:
s_endpgm
.section .rodata,"a"
.p2align 6
.amdhsa_kernel standalone__glu_gated_glu__decode_kernel
  .amdhsa_next_free_vgpr 160
  .amdhsa_next_free_sgpr 100
  .amdhsa_accum_offset 160
  .amdhsa_group_segment_fixed_size 0
  .amdhsa_kernarg_size 56
  .amdhsa_user_sgpr_count 2
  .amdhsa_user_sgpr_kernarg_segment_ptr 1
  .amdhsa_system_sgpr_workgroup_id_x 1
  .amdhsa_float_denorm_mode_32 3
.end_amdhsa_kernel
```
